```python
import torch

def _softmax(x, axis=-1):
    return torch.softmax(x, dim=axis)
def _gelu(x):
    return torch.nn.functional.gelu(x, approximate="tanh")
def _silu(x):
    return torch.nn.functional.silu(x)
def _sigmoid(x):
    return torch.sigmoid(x)
def _layernorm(x, axis=-1, eps=1e-5):
    m = x.mean(dim=axis, keepdim=True)
    v = x.var(dim=axis, keepdim=True, unbiased=False)
    return (x - m) / torch.sqrt(v + eps)
def _scatter_add(tgt, idx, src, axis=0):
    return tgt.clone().index_add_(axis, idx, src)
def _segment_sum(src, seg, n):
    out = torch.zeros((n,) + src.shape[1:], dtype=src.dtype)
    return out.index_add_(0, seg, src)
def _pad(x, pw):
    flat = tuple(v for pair in reversed(pw) for v in pair)
    return torch.nn.functional.pad(x, flat)

kernel_name = 'standalone__sliding_block_cached__decode'

def setup_inputs():

    _w = (lambda a: (lambda t: t.to(torch.bfloat16) if t.is_floating_point() else t)(torch.as_tensor(a)))
    B, Sq, D = 1, 1, 640
    Hq, Hkv, Sk, Dh = 32, 32, 16384, 128
    assert Hq % Hkv == 0, (Hq, Hkv)
    return {
        "x": _w((lambda *s: torch.randn(*s, dtype=torch.bfloat16) * 0.8)(B, Sq, D)),
        "k_cache": _w((lambda *s: torch.randn(*s, dtype=torch.bfloat16) * 0.8)(B, Hkv, Sk, Dh)),
        "v_cache": _w((lambda *s: torch.randn(*s, dtype=torch.bfloat16) * 0.05)(B, Hkv, Sk, Dh)),
        "wq": _w((lambda *s: torch.randn(*s, dtype=torch.bfloat16) * 0.8)(D, Hq * Dh) * (D ** -0.5)),
        "wo": _w((lambda *s: torch.randn(*s, dtype=torch.bfloat16) * 0.05)(Hq * Dh, D) * ((Hq * Dh) ** -0.5)),
    }

def reference(x, k_cache, v_cache, wq, wo):
    B, Sq, D = x.shape
    Hq, Dh = 32, 128
    Hkv, Sk = k_cache.shape[1], k_cache.shape[2]
    W = min(4096, max(256, Sk // 4))
    rep = Hq // Hkv
    q = (lambda x, *d: x.permute(*d))((x @ wq).reshape(B, Sq, Hq, Dh), 0, 2, 1, 3)
    k = (lambda x, n, axis: torch.repeat_interleave(x, n, dim=axis))(k_cache[:, :, Sk - W:, :], rep, axis=1)
    v = (lambda x, n, axis: torch.repeat_interleave(x, n, dim=axis))(v_cache[:, :, Sk - W:, :], rep, axis=1)
    scores = torch.einsum("bhqd,bhkd->bhqk", q, k) * (Dh ** -0.5)
    p = _softmax(scores, axis=-1)
    o = torch.einsum("bhqk,bhkd->bhqd", p, v)
    return (lambda x, *d: x.permute(*d))(o, 0, 2, 1, 3).reshape(B, Sq, Hq * Dh) @ wo
```

```asm
; @launch grid=(256,1,1) block=(1024,1,1) lds=32768
.amdgcn_target "amdgcn-amd-amdhsa--gfx950"
.text
.globl standalone__sliding_block_cached__decode_kernel
.p2align 8
.type standalone__sliding_block_cached__decode_kernel,@function
standalone__sliding_block_cached__decode_kernel:
    s_cmp_ge_u32 s2, 256
    s_cbranch_scc1 L_end
    s_load_dwordx16 s[4:19], s[0:1], 0
    v_mov_b32 v7, 0
    ds_write_b32 v7, v7 offset:256
    s_and_b32 s52, s2, 7
    s_lshl_b32 s52, s52, 2
    s_bfe_u32 s53, s2, 0x20003
    s_add_u32 s52, s52, s53
    s_lshr_b32 s53, s2, 5
    v_and_b32 v1, 63, v0
    v_lshrrev_b32 v44, 6, v0
    v_and_b32 v8, 15, v0
    v_readfirstlane_b32 s54, v44
    v_bfe_u32 v9, v0, 4, 2
    v_lshrrev_b32 v45, 4, v0
    v_lshlrev_b32 v16, 4, v1
    v_mul_u32_u24 v3, 2560, v45
    v_lshl_add_u32 v3, v8, 4, v3
    v_lshlrev_b32 v15, 2, v8
    v_add_u32 v15, v15, v9
    v_lshlrev_b32 v15, 3, v15
    v_lshl_add_u32 v4, v44, 9, v15
    v_lshlrev_b32 v5, 3, v1
    v_lshlrev_b32 v10, 3, v45
    v_lshlrev_b32 v14, 2, v1
    v_mov_b32 v18, 1
    v_mov_b32 v20, -1
    v_mov_b32 v21, -1
    v_mov_b32 v22, -1
    v_mov_b32 v23, -1
    s_mul_i32 s55, s53, 135
    s_mul_i32 s56, s54, 9
    s_add_u32 s55, s55, s56
    s_sub_u32 s55, s55, 144
    s_mul_i32 s56, s54, 5
    s_add_u32 s56, s56, 940
    s_cmp_eq_u32 s54, 0
    s_cselect_b32 s56, 1020, s56
    s_cmp_eq_u32 s53, 0
    s_cselect_b32 s55, s56, s55
    s_max_i32 s55, s55, 0
    s_lshl_b32 s55, s55, 10
    v_add_u32 v2, s55, v16
    s_mov_b32 s58, 4096
    s_mov_b32 s59, 8192
    s_mov_b32 s61, 0x05040100
    s_mov_b32 s62, 0x07060302
    s_mov_b32 s67, 0x3e0293ee
    s_lshl_b32 s55, s52, 22
    s_add_u32 s55, s55, 0x300000
    s_lshl_b32 s63, s52, 14
    s_lshl_b32 s56, s53, 11
    s_add_u32 s65, s63, s56
    s_lshl_b32 s69, s53, 15
    s_add_u32 s69, s69, 524288
    s_lshl_b32 s56, s52, 10
    s_add_u32 s66, s69, s56
    s_mov_b32 s23, 0x00020000
    s_mov_b32 s27, 0x00020000
    s_mov_b32 s31, 0x00020000
    s_mov_b32 s35, 0x00020000
    s_mov_b32 s43, 0x00020000
    s_mov_b32 s47, 0x00020000
    s_mov_b32 s51, 0x00020000
    s_mov_b32 s22, 1048576
    s_mov_b32 s26, 1048576
    s_mov_b32 s42, 1310720
    s_mov_b32 s46, 1280
    s_mov_b32 s50, 256
    s_mov_b32 s30, 5242880
    s_mul_i32 s57, s52, 163840
    s_min_u32 s68, s53, 4
    s_lshl_b32 s68, s68, 8
    s_add_u32 s57, s57, s68
    s_sub_u32 s34, 5242880, s57
    s_cmp_lt_u32 s53, 5
    s_cselect_b32 s34, s34, 0
    s_waitcnt lgkmcnt(0)
    s_add_u32 s20, s6, s55
    s_addc_u32 s21, s7, 0
    s_add_u32 s24, s8, s55
    s_addc_u32 s25, s9, 0
    s_mov_b32 s28, s10
    s_mov_b32 s29, s11
    s_add_u32 s32, s12, s57
    s_addc_u32 s33, s13, 0
    s_mov_b32 s40, s18
    s_mov_b32 s41, s19
    s_mov_b32 s44, s14
    s_mov_b32 s45, s15
    s_mov_b32 s48, s16
    s_mov_b32 s49, s17
    s_cmp_lg_u32 s54, 0
    s_cbranch_scc1 L_notw0
    s_setprio 3
    s_and_b32 s55, s52, 3
    s_lshl_b32 s55, s55, 3
    s_add_u32 s55, s55, s53
    s_lshr_b32 s56, s52, 2
    s_mul_i32 s57, s55, 40
    s_add_u32 s6, s4, s57
    s_addc_u32 s7, s5, 0
    s_load_dwordx8 s[8:15], s[6:7], 0
    s_load_dwordx2 s[16:17], s[6:7], 32
    s_lshl_b32 s60, s55, 14
    s_lshl_b32 s57, s56, 11
    s_add_u32 s60, s60, s57
    s_add_u32 s60, s60, 786432
    s_lshl_b32 s64, s52, 3
    s_add_u32 s64, s64, s53
    buffer_store_dwordx4 v[20:23], v16, s[40:43], s60 offen sc1
    buffer_store_dwordx4 v[20:23], v16, s[40:43], s60 offen offset:1024 sc1
    buffer_store_dwordx4 v[20:23], v16, s[40:43], s65 offen sc1
    buffer_store_dwordx4 v[20:23], v16, s[40:43], s65 offen offset:1024 sc1
    buffer_store_dwordx4 v[20:23], v16, s[40:43], s66 offen sc1
    s_mul_i32 s55, s55, 163840
    s_lshl_b32 s56, s56, 10
    s_add_u32 s55, s55, s56
    buffer_load_dwordx4 v[44:47], v16, s[28:31], s55 offen nt
    s_add_u32 s55, s55, 8192
    buffer_load_dwordx4 v[48:51], v16, s[28:31], s55 offen nt
    s_add_u32 s55, s55, 8192
    buffer_load_dwordx4 v[52:55], v16, s[28:31], s55 offen nt
    s_add_u32 s55, s55, 8192
    buffer_load_dwordx4 v[56:59], v16, s[28:31], s55 offen nt
    s_add_u32 s55, s55, 8192
    buffer_load_dwordx4 v[60:63], v16, s[28:31], s55 offen nt
    s_add_u32 s55, s55, 8192
    buffer_load_dwordx4 v[64:67], v16, s[28:31], s55 offen nt
    s_add_u32 s55, s55, 8192
    buffer_load_dwordx4 v[68:71], v16, s[28:31], s55 offen nt
    s_add_u32 s55, s55, 8192
    buffer_load_dwordx4 v[72:75], v16, s[28:31], s55 offen nt
    s_add_u32 s55, s55, 8192
    buffer_load_dwordx4 v[76:79], v16, s[28:31], s55 offen nt
    s_add_u32 s55, s55, 8192
    buffer_load_dwordx4 v[80:83], v16, s[28:31], s55 offen nt
    s_add_u32 s55, s55, 8192
    buffer_load_dwordx4 v[84:87], v16, s[28:31], s55 offen nt
    s_add_u32 s55, s55, 8192
    buffer_load_dwordx4 v[88:91], v16, s[28:31], s55 offen nt
    s_add_u32 s55, s55, 8192
    buffer_load_dwordx4 v[92:95], v16, s[28:31], s55 offen nt
    s_add_u32 s55, s55, 8192
    buffer_load_dwordx4 v[96:99], v16, s[28:31], s55 offen nt
    s_add_u32 s55, s55, 8192
    buffer_load_dwordx4 v[100:103], v16, s[28:31], s55 offen nt
    s_add_u32 s55, s55, 8192
    buffer_load_dwordx4 v[104:107], v16, s[28:31], s55 offen nt
    s_add_u32 s55, s55, 8192
    buffer_load_dwordx4 v[108:111], v16, s[28:31], s55 offen nt
    s_add_u32 s55, s55, 8192
    buffer_load_dwordx4 v[112:115], v16, s[28:31], s55 offen nt
    s_add_u32 s55, s55, 8192
    buffer_load_dwordx4 v[116:119], v16, s[28:31], s55 offen nt
    s_add_u32 s55, s55, 8192
    buffer_load_dwordx4 v[120:123], v16, s[28:31], s55 offen nt
    s_barrier
    s_waitcnt vmcnt(20)
    s_mov_b64 exec, 1
    buffer_store_byte v18, v7, s[48:51], s64 offen sc1
    s_mov_b64 exec, -1
    v_mov_b32 v20, 0
    v_mov_b32 v21, 0
    v_mov_b32 v22, 0
    v_mov_b32 v23, 0
    v_mov_b32 v24, 0
    v_mov_b32 v25, 0
    v_mov_b32 v26, 0
    v_mov_b32 v27, 0
    s_waitcnt lgkmcnt(0)
    s_waitcnt vmcnt(19)
    v_perm_b32 v32, v48, v44, s61
    v_perm_b32 v33, v48, v44, s62
    v_perm_b32 v34, v49, v45, s61
    v_perm_b32 v35, v49, v45, s62
    v_perm_b32 v36, v50, v46, s61
    v_perm_b32 v37, v50, v46, s62
    v_perm_b32 v38, v51, v47, s61
    v_perm_b32 v39, v51, v47, s62
    v_dot2c_f32_bf16 v20, s8, v32
    v_dot2c_f32_bf16 v21, s8, v33
    v_dot2c_f32_bf16 v22, s8, v34
    v_dot2c_f32_bf16 v23, s8, v35
    v_dot2c_f32_bf16 v24, s8, v36
    v_dot2c_f32_bf16 v25, s8, v37
    v_dot2c_f32_bf16 v26, s8, v38
    v_dot2c_f32_bf16 v27, s8, v39
    s_waitcnt vmcnt(17)
    v_perm_b32 v32, v56, v52, s61
    v_perm_b32 v33, v56, v52, s62
    v_perm_b32 v34, v57, v53, s61
    v_perm_b32 v35, v57, v53, s62
    v_perm_b32 v36, v58, v54, s61
    v_perm_b32 v37, v58, v54, s62
    v_perm_b32 v38, v59, v55, s61
    v_perm_b32 v39, v59, v55, s62
    v_dot2c_f32_bf16 v20, s9, v32
    v_dot2c_f32_bf16 v21, s9, v33
    v_dot2c_f32_bf16 v22, s9, v34
    v_dot2c_f32_bf16 v23, s9, v35
    v_dot2c_f32_bf16 v24, s9, v36
    v_dot2c_f32_bf16 v25, s9, v37
    v_dot2c_f32_bf16 v26, s9, v38
    v_dot2c_f32_bf16 v27, s9, v39
    s_waitcnt vmcnt(15)
    v_perm_b32 v32, v64, v60, s61
    v_perm_b32 v33, v64, v60, s62
    v_perm_b32 v34, v65, v61, s61
    v_perm_b32 v35, v65, v61, s62
    v_perm_b32 v36, v66, v62, s61
    v_perm_b32 v37, v66, v62, s62
    v_perm_b32 v38, v67, v63, s61
    v_perm_b32 v39, v67, v63, s62
    v_dot2c_f32_bf16 v20, s10, v32
    v_dot2c_f32_bf16 v21, s10, v33
    v_dot2c_f32_bf16 v22, s10, v34
    v_dot2c_f32_bf16 v23, s10, v35
    v_dot2c_f32_bf16 v24, s10, v36
    v_dot2c_f32_bf16 v25, s10, v37
    v_dot2c_f32_bf16 v26, s10, v38
    v_dot2c_f32_bf16 v27, s10, v39
    s_waitcnt vmcnt(13)
    v_perm_b32 v32, v72, v68, s61
    v_perm_b32 v33, v72, v68, s62
    v_perm_b32 v34, v73, v69, s61
    v_perm_b32 v35, v73, v69, s62
    v_perm_b32 v36, v74, v70, s61
    v_perm_b32 v37, v74, v70, s62
    v_perm_b32 v38, v75, v71, s61
    v_perm_b32 v39, v75, v71, s62
    v_dot2c_f32_bf16 v20, s11, v32
    v_dot2c_f32_bf16 v21, s11, v33
    v_dot2c_f32_bf16 v22, s11, v34
    v_dot2c_f32_bf16 v23, s11, v35
    v_dot2c_f32_bf16 v24, s11, v36
    v_dot2c_f32_bf16 v25, s11, v37
    v_dot2c_f32_bf16 v26, s11, v38
    v_dot2c_f32_bf16 v27, s11, v39
    s_waitcnt vmcnt(11)
    v_perm_b32 v32, v80, v76, s61
    v_perm_b32 v33, v80, v76, s62
    v_perm_b32 v34, v81, v77, s61
    v_perm_b32 v35, v81, v77, s62
    v_perm_b32 v36, v82, v78, s61
    v_perm_b32 v37, v82, v78, s62
    v_perm_b32 v38, v83, v79, s61
    v_perm_b32 v39, v83, v79, s62
    v_dot2c_f32_bf16 v20, s12, v32
    v_dot2c_f32_bf16 v21, s12, v33
    v_dot2c_f32_bf16 v22, s12, v34
    v_dot2c_f32_bf16 v23, s12, v35
    v_dot2c_f32_bf16 v24, s12, v36
    v_dot2c_f32_bf16 v25, s12, v37
    v_dot2c_f32_bf16 v26, s12, v38
    v_dot2c_f32_bf16 v27, s12, v39
    s_waitcnt vmcnt(9)
    v_perm_b32 v32, v88, v84, s61
    v_perm_b32 v33, v88, v84, s62
    v_perm_b32 v34, v89, v85, s61
    v_perm_b32 v35, v89, v85, s62
    v_perm_b32 v36, v90, v86, s61
    v_perm_b32 v37, v90, v86, s62
    v_perm_b32 v38, v91, v87, s61
    v_perm_b32 v39, v91, v87, s62
    v_dot2c_f32_bf16 v20, s13, v32
    v_dot2c_f32_bf16 v21, s13, v33
    v_dot2c_f32_bf16 v22, s13, v34
    v_dot2c_f32_bf16 v23, s13, v35
    v_dot2c_f32_bf16 v24, s13, v36
    v_dot2c_f32_bf16 v25, s13, v37
    v_dot2c_f32_bf16 v26, s13, v38
    v_dot2c_f32_bf16 v27, s13, v39
    s_waitcnt vmcnt(7)
    v_perm_b32 v32, v96, v92, s61
    v_perm_b32 v33, v96, v92, s62
    v_perm_b32 v34, v97, v93, s61
    v_perm_b32 v35, v97, v93, s62
    v_perm_b32 v36, v98, v94, s61
    v_perm_b32 v37, v98, v94, s62
    v_perm_b32 v38, v99, v95, s61
    v_perm_b32 v39, v99, v95, s62
    v_dot2c_f32_bf16 v20, s14, v32
    v_dot2c_f32_bf16 v21, s14, v33
    v_dot2c_f32_bf16 v22, s14, v34
    v_dot2c_f32_bf16 v23, s14, v35
    v_dot2c_f32_bf16 v24, s14, v36
    v_dot2c_f32_bf16 v25, s14, v37
    v_dot2c_f32_bf16 v26, s14, v38
    v_dot2c_f32_bf16 v27, s14, v39
    s_waitcnt vmcnt(5)
    v_perm_b32 v32, v104, v100, s61
    v_perm_b32 v33, v104, v100, s62
    v_perm_b32 v34, v105, v101, s61
    v_perm_b32 v35, v105, v101, s62
    v_perm_b32 v36, v106, v102, s61
    v_perm_b32 v37, v106, v102, s62
    v_perm_b32 v38, v107, v103, s61
    v_perm_b32 v39, v107, v103, s62
    v_dot2c_f32_bf16 v20, s15, v32
    v_dot2c_f32_bf16 v21, s15, v33
    v_dot2c_f32_bf16 v22, s15, v34
    v_dot2c_f32_bf16 v23, s15, v35
    v_dot2c_f32_bf16 v24, s15, v36
    v_dot2c_f32_bf16 v25, s15, v37
    v_dot2c_f32_bf16 v26, s15, v38
    v_dot2c_f32_bf16 v27, s15, v39
    s_waitcnt vmcnt(3)
    v_perm_b32 v32, v112, v108, s61
    v_perm_b32 v33, v112, v108, s62
    v_perm_b32 v34, v113, v109, s61
    v_perm_b32 v35, v113, v109, s62
    v_perm_b32 v36, v114, v110, s61
    v_perm_b32 v37, v114, v110, s62
    v_perm_b32 v38, v115, v111, s61
    v_perm_b32 v39, v115, v111, s62
    v_dot2c_f32_bf16 v20, s16, v32
    v_dot2c_f32_bf16 v21, s16, v33
    v_dot2c_f32_bf16 v22, s16, v34
    v_dot2c_f32_bf16 v23, s16, v35
    v_dot2c_f32_bf16 v24, s16, v36
    v_dot2c_f32_bf16 v25, s16, v37
    v_dot2c_f32_bf16 v26, s16, v38
    v_dot2c_f32_bf16 v27, s16, v39
    s_waitcnt vmcnt(1)
    v_perm_b32 v32, v120, v116, s61
    v_perm_b32 v33, v120, v116, s62
    v_perm_b32 v34, v121, v117, s61
    v_perm_b32 v35, v121, v117, s62
    v_perm_b32 v36, v122, v118, s61
    v_perm_b32 v37, v122, v118, s62
    v_perm_b32 v38, v123, v119, s61
    v_perm_b32 v39, v123, v119, s62
    v_dot2c_f32_bf16 v20, s17, v32
    v_dot2c_f32_bf16 v21, s17, v33
    v_dot2c_f32_bf16 v22, s17, v34
    v_dot2c_f32_bf16 v23, s17, v35
    v_dot2c_f32_bf16 v24, s17, v36
    v_dot2c_f32_bf16 v25, s17, v37
    v_dot2c_f32_bf16 v26, s17, v38
    v_dot2c_f32_bf16 v27, s17, v39
    v_lshlrev_b32 v6, 5, v1
    s_nop 1
    v_min_u32 v20, -2, v20
    v_min_u32 v21, -2, v21
    v_min_u32 v22, -2, v22
    v_min_u32 v23, -2, v23
    v_min_u32 v24, -2, v24
    v_min_u32 v25, -2, v25
    v_min_u32 v26, -2, v26
    v_min_u32 v27, -2, v27
    buffer_store_dwordx4 v[20:23], v6, s[40:43], s60 offen sc1
    buffer_store_dwordx4 v[24:27], v6, s[40:43], s60 offen offset:16 sc1
    s_barrier
    v_and_b32 v6, 7, v1
    v_lshlrev_b32 v6, 2, v6
    s_lshr_b32 s57, s52, 2
    s_lshl_b32 s57, s57, 5
    v_mov_b32 v28, 0x01010101
    v_lshlrev_b32 v29, 2, v1
    s_cmp_eq_u32 s53, 0
    s_cbranch_scc1 L_pollr_s
    s_mov_b32 s68, 0
    s_mov_b32 s55, 0
L_pollq:
    s_cmp_lg_u32 s55, 0
    s_cbranch_scc1 L_pollq_nr
    buffer_load_dword v13, v6, s[48:51], s57 offen sc1
L_pollq_nr:
    buffer_load_dword v20, v29, s[40:43], s63 offen offset:1024 sc1
    s_waitcnt vmcnt(0)
    v_cmp_eq_u32 vcc, -1, v20
    s_add_u32 s68, s68, 1
    s_cmp_ge_u32 s68, 1048576
    s_cbranch_scc1 L_pollq_done
    s_cmp_eq_u64 vcc, 0
    s_cselect_b32 s56, s55, 0
    s_cmp_lg_u32 s56, 0
    s_cbranch_scc1 L_pollq_done
    v_cmp_ne_u32 vcc, v28, v13
    s_nop 4
    s_cmp_eq_u64 vcc, 0
    s_cselect_b32 s55, 1, 0
    s_branch L_pollq
L_pollq_done:
    v_mov_b32 v6, v29
    buffer_load_dwordx4 v[52:55], v3, s[32:35], 0 offen offset:0 nt
    buffer_load_dwordx4 v[56:59], v3, s[32:35], 0 offen offset:1280 nt
    ds_write_b32 v6, v20 offset:0
    s_waitcnt lgkmcnt(0)
    ds_write_b32 v7, v18 offset:256
    s_setprio 0
    v_mov_b32 v11, 0xff800000
    v_mov_b32 v12, 0
    v_mov_b32 v20, 0
    v_mov_b32 v21, 0
    s_branch L_tail
L_pollr_s:
    s_mov_b32 s68, 0
L_pollr:
    buffer_load_dword v13, v6, s[48:51], s57 offen sc1
    s_waitcnt vmcnt(0)
    v_cmp_ne_u32 vcc, v28, v13
    s_add_u32 s68, s68, 1
    s_cmp_ge_u32 s68, 1048576
    s_cbranch_scc1 L_pollr_done
    s_cbranch_vccz L_pollr_done
    s_sleep 2
    s_branch L_pollr
L_pollr_done:
    v_mov_b32 v6, v29
    s_mov_b32 s68, 0
L_pollp:
    s_lshl_b32 s55, s52, 9
    s_add_u32 s55, s55, 786432
    buffer_load_dwordx2 v[60:61], v5, s[40:43], s55 offen sc1
    s_add_u32 s55, s55, 16384
    buffer_load_dwordx2 v[62:63], v5, s[40:43], s55 offen sc1
    s_add_u32 s55, s55, 16384
    buffer_load_dwordx2 v[64:65], v5, s[40:43], s55 offen sc1
    s_add_u32 s55, s55, 16384
    buffer_load_dwordx2 v[66:67], v5, s[40:43], s55 offen sc1
    s_add_u32 s55, s55, 16384
    buffer_load_dwordx2 v[68:69], v5, s[40:43], s55 offen sc1
    s_add_u32 s55, s55, 16384
    buffer_load_dwordx2 v[70:71], v5, s[40:43], s55 offen sc1
    s_add_u32 s55, s55, 16384
    buffer_load_dwordx2 v[72:73], v5, s[40:43], s55 offen sc1
    s_add_u32 s55, s55, 16384
    buffer_load_dwordx2 v[74:75], v5, s[40:43], s55 offen sc1
    s_add_u32 s55, s55, 16384
    buffer_load_dwordx2 v[76:77], v5, s[40:43], s55 offen sc1
    s_add_u32 s55, s55, 16384
    buffer_load_dwordx2 v[78:79], v5, s[40:43], s55 offen sc1
    s_add_u32 s55, s55, 16384
    buffer_load_dwordx2 v[80:81], v5, s[40:43], s55 offen sc1
    s_add_u32 s55, s55, 16384
    buffer_load_dwordx2 v[82:83], v5, s[40:43], s55 offen sc1
    s_add_u32 s55, s55, 16384
    buffer_load_dwordx2 v[84:85], v5, s[40:43], s55 offen sc1
    s_add_u32 s55, s55, 16384
    buffer_load_dwordx2 v[86:87], v5, s[40:43], s55 offen sc1
    s_add_u32 s55, s55, 16384
    buffer_load_dwordx2 v[88:89], v5, s[40:43], s55 offen sc1
    s_add_u32 s55, s55, 16384
    buffer_load_dwordx2 v[90:91], v5, s[40:43], s55 offen sc1
    s_add_u32 s55, s55, 16384
    buffer_load_dwordx2 v[92:93], v5, s[40:43], s55 offen sc1
    s_add_u32 s55, s55, 16384
    buffer_load_dwordx2 v[94:95], v5, s[40:43], s55 offen sc1
    s_add_u32 s55, s55, 16384
    buffer_load_dwordx2 v[96:97], v5, s[40:43], s55 offen sc1
    s_add_u32 s55, s55, 16384
    buffer_load_dwordx2 v[98:99], v5, s[40:43], s55 offen sc1
    s_add_u32 s55, s55, 16384
    buffer_load_dwordx2 v[100:101], v5, s[40:43], s55 offen sc1
    s_add_u32 s55, s55, 16384
    buffer_load_dwordx2 v[102:103], v5, s[40:43], s55 offen sc1
    s_add_u32 s55, s55, 16384
    buffer_load_dwordx2 v[104:105], v5, s[40:43], s55 offen sc1
    s_add_u32 s55, s55, 16384
    buffer_load_dwordx2 v[106:107], v5, s[40:43], s55 offen sc1
    s_add_u32 s55, s55, 16384
    buffer_load_dwordx2 v[108:109], v5, s[40:43], s55 offen sc1
    s_add_u32 s55, s55, 16384
    buffer_load_dwordx2 v[110:111], v5, s[40:43], s55 offen sc1
    s_add_u32 s55, s55, 16384
    buffer_load_dwordx2 v[112:113], v5, s[40:43], s55 offen sc1
    s_add_u32 s55, s55, 16384
    buffer_load_dwordx2 v[114:115], v5, s[40:43], s55 offen sc1
    s_add_u32 s55, s55, 16384
    buffer_load_dwordx2 v[116:117], v5, s[40:43], s55 offen sc1
    s_add_u32 s55, s55, 16384
    buffer_load_dwordx2 v[118:119], v5, s[40:43], s55 offen sc1
    s_add_u32 s55, s55, 16384
    buffer_load_dwordx2 v[120:121], v5, s[40:43], s55 offen sc1
    s_add_u32 s55, s55, 16384
    buffer_load_dwordx2 v[122:123], v5, s[40:43], s55 offen sc1
    s_waitcnt vmcnt(0)
    v_max3_u32 v44, v60, v61, v62
    v_max3_u32 v44, v44, v63, v64
    v_max3_u32 v44, v44, v65, v66
    v_max3_u32 v44, v44, v67, v68
    v_max3_u32 v44, v44, v69, v70
    v_max3_u32 v44, v44, v71, v72
    v_max3_u32 v44, v44, v73, v74
    v_max3_u32 v44, v44, v75, v76
    v_max3_u32 v44, v44, v77, v78
    v_max3_u32 v44, v44, v79, v80
    v_max3_u32 v44, v44, v81, v82
    v_max3_u32 v44, v44, v83, v84
    v_max3_u32 v44, v44, v85, v86
    v_max3_u32 v44, v44, v87, v88
    v_max3_u32 v44, v44, v89, v90
    v_max3_u32 v44, v44, v91, v92
    v_max3_u32 v44, v44, v93, v94
    v_max3_u32 v44, v44, v95, v96
    v_max3_u32 v44, v44, v97, v98
    v_max3_u32 v44, v44, v99, v100
    v_max3_u32 v44, v44, v101, v102
    v_max3_u32 v44, v44, v103, v104
    v_max3_u32 v44, v44, v105, v106
    v_max3_u32 v44, v44, v107, v108
    v_max3_u32 v44, v44, v109, v110
    v_max3_u32 v44, v44, v111, v112
    v_max3_u32 v44, v44, v113, v114
    v_max3_u32 v44, v44, v115, v116
    v_max3_u32 v44, v44, v117, v118
    v_max3_u32 v44, v44, v119, v120
    v_max3_u32 v44, v44, v121, v122
    v_max_u32 v44, v44, v123
    v_cmp_eq_u32 vcc, -1, v44
    s_add_u32 s68, s68, 1
    s_cmp_ge_u32 s68, 1048576
    s_cbranch_scc1 L_pollp_done
    s_cbranch_vccz L_pollp_done
    s_sleep 4
    s_branch L_pollp
L_pollp_done:
    v_add_f32 v60, v60, v62
    v_add_f32 v61, v61, v63
    v_add_f32 v64, v64, v66
    v_add_f32 v65, v65, v67
    v_add_f32 v68, v68, v70
    v_add_f32 v69, v69, v71
    v_add_f32 v72, v72, v74
    v_add_f32 v73, v73, v75
    v_add_f32 v76, v76, v78
    v_add_f32 v77, v77, v79
    v_add_f32 v80, v80, v82
    v_add_f32 v81, v81, v83
    v_add_f32 v84, v84, v86
    v_add_f32 v85, v85, v87
    v_add_f32 v88, v88, v90
    v_add_f32 v89, v89, v91
    v_add_f32 v92, v92, v94
    v_add_f32 v93, v93, v95
    v_add_f32 v96, v96, v98
    v_add_f32 v97, v97, v99
    v_add_f32 v100, v100, v102
    v_add_f32 v101, v101, v103
    v_add_f32 v104, v104, v106
    v_add_f32 v105, v105, v107
    v_add_f32 v108, v108, v110
    v_add_f32 v109, v109, v111
    v_add_f32 v112, v112, v114
    v_add_f32 v113, v113, v115
    v_add_f32 v116, v116, v118
    v_add_f32 v117, v117, v119
    v_add_f32 v120, v120, v122
    v_add_f32 v121, v121, v123
    v_add_f32 v60, v60, v64
    v_add_f32 v61, v61, v65
    v_add_f32 v68, v68, v72
    v_add_f32 v69, v69, v73
    v_add_f32 v76, v76, v80
    v_add_f32 v77, v77, v81
    v_add_f32 v84, v84, v88
    v_add_f32 v85, v85, v89
    v_add_f32 v92, v92, v96
    v_add_f32 v93, v93, v97
    v_add_f32 v100, v100, v104
    v_add_f32 v101, v101, v105
    v_add_f32 v108, v108, v112
    v_add_f32 v109, v109, v113
    v_add_f32 v116, v116, v120
    v_add_f32 v117, v117, v121
    v_add_f32 v60, v60, v68
    v_add_f32 v61, v61, v69
    v_add_f32 v76, v76, v84
    v_add_f32 v77, v77, v85
    v_add_f32 v92, v92, v100
    v_add_f32 v93, v93, v101
    v_add_f32 v108, v108, v116
    v_add_f32 v109, v109, v117
    v_add_f32 v60, v60, v76
    v_add_f32 v61, v61, v77
    v_add_f32 v92, v92, v108
    v_add_f32 v93, v93, v109
    v_add_f32 v20, v60, v92
    v_add_f32 v21, v61, v93
    v_cvt_pk_bf16_f32 v20, v20, v21
    v_min_u32 v20, -2, v20
    buffer_store_dword v20, v6, s[40:43], s63 offen offset:1024 sc1
    ds_write_b32 v6, v20 offset:0
    s_waitcnt lgkmcnt(0)
    ds_write_b32 v7, v18 offset:256
    s_setprio 0
    s_waitcnt vmcnt(0)
    v_lshlrev_b32 v6, 4, v8
    s_mov_b32 s68, 0
L_waitqs0:
    ds_read_b32 v44, v7 offset:256
    s_waitcnt lgkmcnt(0)
    v_readfirstlane_b32 s56, v44
    s_add_u32 s68, s68, 1
    s_cmp_ge_u32 s68, 1048576
    s_cbranch_scc1 L_waitqs0_done
    s_cmp_ge_u32 s56, 1
    s_cbranch_scc1 L_waitqs0_done
    s_sleep 1
    s_branch L_waitqs0
L_waitqs0_done:
    ds_read_b128 v[28:31], v6 offset:0
    buffer_load_dwordx4 v[52:55], v2, s[20:23], 0 offen offset:0 nt
    buffer_load_dwordx4 v[56:59], v2, s[20:23], 0 offen offset:1024 nt
    buffer_load_dwordx4 v[60:63], v2, s[20:23], 0 offen offset:2048 nt
    buffer_load_dwordx4 v[64:67], v2, s[20:23], 0 offen offset:3072 nt
    buffer_load_dwordx4 v[88:91], v2, s[24:27], 0 offen offset:0 nt
    buffer_load_dwordx4 v[92:95], v2, s[24:27], 0 offen offset:1024 nt
    buffer_load_dwordx4 v[96:99], v2, s[24:27], 0 offen offset:2048 nt
    buffer_load_dwordx4 v[100:103], v2, s[24:27], 0 offen offset:3072 nt
    s_waitcnt lgkmcnt(0)
    s_waitcnt vmcnt(5)
    v_dot2_f32_bf16 v32, v52, v28, 0
    v_dot2_f32_bf16 v33, v56, v28, 0
    v_dot2_f32_bf16 v34, v60, v28, 0
    v_dot2_f32_bf16 v32, v53, v29, v32
    v_dot2_f32_bf16 v33, v57, v29, v33
    v_dot2_f32_bf16 v34, v61, v29, v34
    v_dot2_f32_bf16 v32, v54, v30, v32
    v_dot2_f32_bf16 v33, v58, v30, v33
    v_dot2_f32_bf16 v34, v62, v30, v34
    v_dot2_f32_bf16 v32, v55, v31, v32
    v_dot2_f32_bf16 v33, v59, v31, v33
    v_dot2_f32_bf16 v34, v63, v31, v34
    s_nop 2
    v_add_f32_dpp v32, v32, v32 row_ror:8 row_mask:0xf bank_mask:0xf
    v_add_f32_dpp v33, v33, v33 row_ror:8 row_mask:0xf bank_mask:0xf
    v_add_f32_dpp v34, v34, v34 row_ror:8 row_mask:0xf bank_mask:0xf
    v_add_f32_dpp v32, v32, v32 row_ror:4 row_mask:0xf bank_mask:0xf
    v_add_f32_dpp v33, v33, v33 row_ror:4 row_mask:0xf bank_mask:0xf
    v_add_f32_dpp v34, v34, v34 row_ror:4 row_mask:0xf bank_mask:0xf
    v_add_f32_dpp v32, v32, v32 row_ror:2 row_mask:0xf bank_mask:0xf
    v_add_f32_dpp v33, v33, v33 row_ror:2 row_mask:0xf bank_mask:0xf
    v_add_f32_dpp v34, v34, v34 row_ror:2 row_mask:0xf bank_mask:0xf
    v_add_f32_dpp v32, v32, v32 row_ror:1 row_mask:0xf bank_mask:0xf
    v_add_f32_dpp v33, v33, v33 row_ror:1 row_mask:0xf bank_mask:0xf
    v_add_f32_dpp v34, v34, v34 row_ror:1 row_mask:0xf bank_mask:0xf
    s_waitcnt vmcnt(4)
    v_dot2_f32_bf16 v35, v64, v28, 0
    v_dot2_f32_bf16 v35, v65, v29, v35
    v_dot2_f32_bf16 v35, v66, v30, v35
    v_dot2_f32_bf16 v35, v67, v31, v35
    s_nop 2
    v_add_f32_dpp v35, v35, v35 row_ror:8 row_mask:0xf bank_mask:0xf
    s_nop 1
    v_add_f32_dpp v35, v35, v35 row_ror:4 row_mask:0xf bank_mask:0xf
    s_nop 1
    v_add_f32_dpp v35, v35, v35 row_ror:2 row_mask:0xf bank_mask:0xf
    s_nop 1
    v_add_f32_dpp v35, v35, v35 row_ror:1 row_mask:0xf bank_mask:0xf
    s_nop 1
    buffer_load_dwordx4 v[52:55], v3, s[32:35], 0 offen offset:0 nt
    buffer_load_dwordx4 v[56:59], v3, s[32:35], 0 offen offset:1280 nt
    v_max3_f32 v11, v32, v33, v34
    v_max_f32 v11, v11, v35
    v_mov_b32 v44, v11
    s_nop 1
    v_permlane32_swap_b32 v11, v44
    v_max_f32 v11, v11, v44
    v_mov_b32 v44, v11
    s_nop 1
    v_permlane16_swap_b32 v11, v44
    v_max_f32 v11, v11, v44
    v_mul_f32 v11, s67, v11
    v_fma_f32 v32, v32, s67, -v11
    v_fma_f32 v33, v33, s67, -v11
    v_fma_f32 v34, v34, s67, -v11
    v_fma_f32 v35, v35, s67, -v11
    v_exp_f32 v32, v32
    v_exp_f32 v33, v33
    v_exp_f32 v34, v34
    v_exp_f32 v35, v35
    s_nop 0
    v_add_f32 v12, v32, v33
    v_add_f32 v12, v12, v34
    v_add_f32 v12, v12, v35
    v_mov_b32 v44, v12
    s_nop 1
    v_permlane32_swap_b32 v12, v44
    v_add_f32 v12, v12, v44
    v_mov_b32 v44, v12
    s_nop 1
    v_permlane16_swap_b32 v12, v44
    v_add_f32 v12, v12, v44
    s_waitcnt vmcnt(5)
    v_lshlrev_b32 v44, 16, v88
    v_and_b32 v45, 0xffff0000, v88
    v_lshlrev_b32 v46, 16, v89
    v_and_b32 v47, 0xffff0000, v89
    v_lshlrev_b32 v48, 16, v90
    v_and_b32 v49, 0xffff0000, v90
    v_lshlrev_b32 v50, 16, v91
    v_and_b32 v51, 0xffff0000, v91
    v_mul_f32 v20, v44, v32
    v_mul_f32 v21, v45, v32
    v_mul_f32 v22, v46, v32
    v_mul_f32 v23, v47, v32
    v_mul_f32 v24, v48, v32
    v_mul_f32 v25, v49, v32
    v_mul_f32 v26, v50, v32
    v_mul_f32 v27, v51, v32
    s_waitcnt vmcnt(4)
    v_lshlrev_b32 v44, 16, v92
    v_and_b32 v45, 0xffff0000, v92
    v_lshlrev_b32 v46, 16, v93
    v_and_b32 v47, 0xffff0000, v93
    v_lshlrev_b32 v48, 16, v94
    v_and_b32 v49, 0xffff0000, v94
    v_lshlrev_b32 v50, 16, v95
    v_and_b32 v51, 0xffff0000, v95
    v_fmac_f32 v20, v44, v33
    v_fmac_f32 v21, v45, v33
    v_fmac_f32 v22, v46, v33
    v_fmac_f32 v23, v47, v33
    v_fmac_f32 v24, v48, v33
    v_fmac_f32 v25, v49, v33
    v_fmac_f32 v26, v50, v33
    v_fmac_f32 v27, v51, v33
    s_waitcnt vmcnt(3)
    v_lshlrev_b32 v44, 16, v96
    v_and_b32 v45, 0xffff0000, v96
    v_lshlrev_b32 v46, 16, v97
    v_and_b32 v47, 0xffff0000, v97
    v_lshlrev_b32 v48, 16, v98
    v_and_b32 v49, 0xffff0000, v98
    v_lshlrev_b32 v50, 16, v99
    v_and_b32 v51, 0xffff0000, v99
    v_fmac_f32 v20, v44, v34
    v_fmac_f32 v21, v45, v34
    v_fmac_f32 v22, v46, v34
    v_fmac_f32 v23, v47, v34
    v_fmac_f32 v24, v48, v34
    v_fmac_f32 v25, v49, v34
    v_fmac_f32 v26, v50, v34
    v_fmac_f32 v27, v51, v34
    s_waitcnt vmcnt(2)
    v_lshlrev_b32 v44, 16, v100
    v_and_b32 v45, 0xffff0000, v100
    v_lshlrev_b32 v46, 16, v101
    v_and_b32 v47, 0xffff0000, v101
    v_lshlrev_b32 v48, 16, v102
    v_and_b32 v49, 0xffff0000, v102
    v_lshlrev_b32 v50, 16, v103
    v_and_b32 v51, 0xffff0000, v103
    v_fmac_f32 v20, v44, v35
    v_fmac_f32 v21, v45, v35
    v_fmac_f32 v22, v46, v35
    v_fmac_f32 v23, v47, v35
    v_fmac_f32 v24, v48, v35
    v_fmac_f32 v25, v49, v35
    v_fmac_f32 v26, v50, v35
    v_fmac_f32 v27, v51, v35
    s_nop 1
    v_permlane32_swap_b32 v20, v24
    v_permlane32_swap_b32 v21, v25
    v_permlane32_swap_b32 v22, v26
    v_permlane32_swap_b32 v23, v27
    v_add_f32 v20, v20, v24
    v_add_f32 v21, v21, v25
    v_add_f32 v22, v22, v26
    v_add_f32 v23, v23, v27
    s_nop 1
    v_permlane16_swap_b32 v20, v22
    v_permlane16_swap_b32 v21, v23
    v_add_f32 v20, v20, v22
    v_add_f32 v21, v21, v23
    s_branch L_tail
L_notw0:
    s_barrier
    s_cmp_eq_u32 s53, 0
    s_cbranch_scc1 L_s_stream
    s_barrier
    buffer_load_dwordx4 v[52:55], v2, s[20:23], 0 offen offset:0 nt
    buffer_load_dwordx4 v[56:59], v2, s[20:23], 0 offen offset:1024 nt
    buffer_load_dwordx4 v[60:63], v2, s[20:23], 0 offen offset:2048 nt
    buffer_load_dwordx4 v[64:67], v2, s[20:23], 0 offen offset:3072 nt
    buffer_load_dwordx4 v[68:71], v2, s[20:23], s58 offen offset:0 nt
    buffer_load_dwordx4 v[72:75], v2, s[20:23], s58 offen offset:1024 nt
    buffer_load_dwordx4 v[76:79], v2, s[20:23], s58 offen offset:2048 nt
    buffer_load_dwordx4 v[80:83], v2, s[20:23], s58 offen offset:3072 nt
    buffer_load_dwordx4 v[84:87], v2, s[20:23], s59 offen offset:0 nt
    buffer_load_dwordx4 v[88:91], v2, s[24:27], 0 offen offset:0 nt
    buffer_load_dwordx4 v[92:95], v2, s[24:27], 0 offen offset:1024 nt
    buffer_load_dwordx4 v[96:99], v2, s[24:27], 0 offen offset:2048 nt
    buffer_load_dwordx4 v[100:103], v2, s[24:27], 0 offen offset:3072 nt
    buffer_load_dwordx4 v[104:107], v2, s[24:27], s58 offen offset:0 nt
    buffer_load_dwordx4 v[108:111], v2, s[24:27], s58 offen offset:1024 nt
    buffer_load_dwordx4 v[112:115], v2, s[24:27], s58 offen offset:2048 nt
    buffer_load_dwordx4 v[116:119], v2, s[24:27], s58 offen offset:3072 nt
    buffer_load_dwordx4 v[120:123], v2, s[24:27], s59 offen offset:0 nt
    v_lshlrev_b32 v6, 4, v8
    s_mov_b32 s68, 0
L_waitqt:
    ds_read_b32 v44, v7 offset:256
    s_waitcnt lgkmcnt(0)
    v_readfirstlane_b32 s56, v44
    s_add_u32 s68, s68, 1
    s_cmp_ge_u32 s68, 1048576
    s_cbranch_scc1 L_waitqt_done
    s_cmp_ge_u32 s56, 1
    s_cbranch_scc1 L_waitqt_done
    s_sleep 1
    s_branch L_waitqt
L_waitqt_done:
    ds_read_b128 v[28:31], v6 offset:0
    s_waitcnt lgkmcnt(0)
    s_waitcnt vmcnt(15)
    v_dot2_f32_bf16 v32, v52, v28, 0
    v_dot2_f32_bf16 v33, v56, v28, 0
    v_dot2_f32_bf16 v34, v60, v28, 0
    v_dot2_f32_bf16 v32, v53, v29, v32
    v_dot2_f32_bf16 v33, v57, v29, v33
    v_dot2_f32_bf16 v34, v61, v29, v34
    v_dot2_f32_bf16 v32, v54, v30, v32
    v_dot2_f32_bf16 v33, v58, v30, v33
    v_dot2_f32_bf16 v34, v62, v30, v34
    v_dot2_f32_bf16 v32, v55, v31, v32
    v_dot2_f32_bf16 v33, v59, v31, v33
    v_dot2_f32_bf16 v34, v63, v31, v34
    s_nop 2
    v_add_f32_dpp v32, v32, v32 row_ror:8 row_mask:0xf bank_mask:0xf
    v_add_f32_dpp v33, v33, v33 row_ror:8 row_mask:0xf bank_mask:0xf
    v_add_f32_dpp v34, v34, v34 row_ror:8 row_mask:0xf bank_mask:0xf
    v_add_f32_dpp v32, v32, v32 row_ror:4 row_mask:0xf bank_mask:0xf
    v_add_f32_dpp v33, v33, v33 row_ror:4 row_mask:0xf bank_mask:0xf
    v_add_f32_dpp v34, v34, v34 row_ror:4 row_mask:0xf bank_mask:0xf
    v_add_f32_dpp v32, v32, v32 row_ror:2 row_mask:0xf bank_mask:0xf
    v_add_f32_dpp v33, v33, v33 row_ror:2 row_mask:0xf bank_mask:0xf
    v_add_f32_dpp v34, v34, v34 row_ror:2 row_mask:0xf bank_mask:0xf
    v_add_f32_dpp v32, v32, v32 row_ror:1 row_mask:0xf bank_mask:0xf
    v_add_f32_dpp v33, v33, v33 row_ror:1 row_mask:0xf bank_mask:0xf
    v_add_f32_dpp v34, v34, v34 row_ror:1 row_mask:0xf bank_mask:0xf
    s_waitcnt vmcnt(12)
    v_dot2_f32_bf16 v35, v64, v28, 0
    v_dot2_f32_bf16 v36, v68, v28, 0
    v_dot2_f32_bf16 v37, v72, v28, 0
    v_dot2_f32_bf16 v35, v65, v29, v35
    v_dot2_f32_bf16 v36, v69, v29, v36
    v_dot2_f32_bf16 v37, v73, v29, v37
    v_dot2_f32_bf16 v35, v66, v30, v35
    v_dot2_f32_bf16 v36, v70, v30, v36
    v_dot2_f32_bf16 v37, v74, v30, v37
    v_dot2_f32_bf16 v35, v67, v31, v35
    v_dot2_f32_bf16 v36, v71, v31, v36
    v_dot2_f32_bf16 v37, v75, v31, v37
    s_nop 2
    v_add_f32_dpp v35, v35, v35 row_ror:8 row_mask:0xf bank_mask:0xf
    v_add_f32_dpp v36, v36, v36 row_ror:8 row_mask:0xf bank_mask:0xf
    v_add_f32_dpp v37, v37, v37 row_ror:8 row_mask:0xf bank_mask:0xf
    v_add_f32_dpp v35, v35, v35 row_ror:4 row_mask:0xf bank_mask:0xf
    v_add_f32_dpp v36, v36, v36 row_ror:4 row_mask:0xf bank_mask:0xf
    v_add_f32_dpp v37, v37, v37 row_ror:4 row_mask:0xf bank_mask:0xf
    v_add_f32_dpp v35, v35, v35 row_ror:2 row_mask:0xf bank_mask:0xf
    v_add_f32_dpp v36, v36, v36 row_ror:2 row_mask:0xf bank_mask:0xf
    v_add_f32_dpp v37, v37, v37 row_ror:2 row_mask:0xf bank_mask:0xf
    v_add_f32_dpp v35, v35, v35 row_ror:1 row_mask:0xf bank_mask:0xf
    v_add_f32_dpp v36, v36, v36 row_ror:1 row_mask:0xf bank_mask:0xf
    v_add_f32_dpp v37, v37, v37 row_ror:1 row_mask:0xf bank_mask:0xf
    s_waitcnt vmcnt(9)
    v_dot2_f32_bf16 v38, v76, v28, 0
    v_dot2_f32_bf16 v39, v80, v28, 0
    v_dot2_f32_bf16 v40, v84, v28, 0
    v_dot2_f32_bf16 v38, v77, v29, v38
    v_dot2_f32_bf16 v39, v81, v29, v39
    v_dot2_f32_bf16 v40, v85, v29, v40
    v_dot2_f32_bf16 v38, v78, v30, v38
    v_dot2_f32_bf16 v39, v82, v30, v39
    v_dot2_f32_bf16 v40, v86, v30, v40
    v_dot2_f32_bf16 v38, v79, v31, v38
    v_dot2_f32_bf16 v39, v83, v31, v39
    v_dot2_f32_bf16 v40, v87, v31, v40
    s_nop 2
    v_add_f32_dpp v38, v38, v38 row_ror:8 row_mask:0xf bank_mask:0xf
    v_add_f32_dpp v39, v39, v39 row_ror:8 row_mask:0xf bank_mask:0xf
    v_add_f32_dpp v40, v40, v40 row_ror:8 row_mask:0xf bank_mask:0xf
    v_add_f32_dpp v38, v38, v38 row_ror:4 row_mask:0xf bank_mask:0xf
    v_add_f32_dpp v39, v39, v39 row_ror:4 row_mask:0xf bank_mask:0xf
    v_add_f32_dpp v40, v40, v40 row_ror:4 row_mask:0xf bank_mask:0xf
    v_add_f32_dpp v38, v38, v38 row_ror:2 row_mask:0xf bank_mask:0xf
    v_add_f32_dpp v39, v39, v39 row_ror:2 row_mask:0xf bank_mask:0xf
    v_add_f32_dpp v40, v40, v40 row_ror:2 row_mask:0xf bank_mask:0xf
    v_add_f32_dpp v38, v38, v38 row_ror:1 row_mask:0xf bank_mask:0xf
    v_add_f32_dpp v39, v39, v39 row_ror:1 row_mask:0xf bank_mask:0xf
    v_add_f32_dpp v40, v40, v40 row_ror:1 row_mask:0xf bank_mask:0xf
    buffer_load_dwordx4 v[52:55], v3, s[32:35], 0 offen offset:0 nt
    buffer_load_dwordx4 v[56:59], v3, s[32:35], 0 offen offset:1280 nt
    v_max3_f32 v11, v32, v33, v34
    v_max3_f32 v11, v11, v35, v36
    v_max3_f32 v11, v11, v37, v38
    v_max3_f32 v11, v11, v39, v40
    v_mov_b32 v44, v11
    s_nop 1
    v_permlane32_swap_b32 v11, v44
    v_max_f32 v11, v11, v44
    v_mov_b32 v44, v11
    s_nop 1
    v_permlane16_swap_b32 v11, v44
    v_max_f32 v11, v11, v44
    v_mul_f32 v11, s67, v11
    v_fma_f32 v32, v32, s67, -v11
    v_fma_f32 v33, v33, s67, -v11
    v_fma_f32 v34, v34, s67, -v11
    v_fma_f32 v35, v35, s67, -v11
    v_fma_f32 v36, v36, s67, -v11
    v_fma_f32 v37, v37, s67, -v11
    v_fma_f32 v38, v38, s67, -v11
    v_fma_f32 v39, v39, s67, -v11
    v_fma_f32 v40, v40, s67, -v11
    v_exp_f32 v32, v32
    v_exp_f32 v33, v33
    v_exp_f32 v34, v34
    v_exp_f32 v35, v35
    v_exp_f32 v36, v36
    v_exp_f32 v37, v37
    v_exp_f32 v38, v38
    v_exp_f32 v39, v39
    v_exp_f32 v40, v40
    s_nop 0
    v_add_f32 v12, v32, v33
    v_add_f32 v12, v12, v34
    v_add_f32 v12, v12, v35
    v_add_f32 v12, v12, v36
    v_add_f32 v12, v12, v37
    v_add_f32 v12, v12, v38
    v_add_f32 v12, v12, v39
    v_add_f32 v12, v12, v40
    v_mov_b32 v44, v12
    s_nop 1
    v_permlane32_swap_b32 v12, v44
    v_add_f32 v12, v12, v44
    v_mov_b32 v44, v12
    s_nop 1
    v_permlane16_swap_b32 v12, v44
    v_add_f32 v12, v12, v44
    s_waitcnt vmcnt(10)
    v_lshlrev_b32 v44, 16, v88
    v_and_b32 v45, 0xffff0000, v88
    v_lshlrev_b32 v46, 16, v89
    v_and_b32 v47, 0xffff0000, v89
    v_lshlrev_b32 v48, 16, v90
    v_and_b32 v49, 0xffff0000, v90
    v_lshlrev_b32 v50, 16, v91
    v_and_b32 v51, 0xffff0000, v91
    v_mul_f32 v20, v44, v32
    v_mul_f32 v21, v45, v32
    v_mul_f32 v22, v46, v32
    v_mul_f32 v23, v47, v32
    v_mul_f32 v24, v48, v32
    v_mul_f32 v25, v49, v32
    v_mul_f32 v26, v50, v32
    v_mul_f32 v27, v51, v32
    s_waitcnt vmcnt(9)
    v_lshlrev_b32 v44, 16, v92
    v_and_b32 v45, 0xffff0000, v92
    v_lshlrev_b32 v46, 16, v93
    v_and_b32 v47, 0xffff0000, v93
    v_lshlrev_b32 v48, 16, v94
    v_and_b32 v49, 0xffff0000, v94
    v_lshlrev_b32 v50, 16, v95
    v_and_b32 v51, 0xffff0000, v95
    v_fmac_f32 v20, v44, v33
    v_fmac_f32 v21, v45, v33
    v_fmac_f32 v22, v46, v33
    v_fmac_f32 v23, v47, v33
    v_fmac_f32 v24, v48, v33
    v_fmac_f32 v25, v49, v33
    v_fmac_f32 v26, v50, v33
    v_fmac_f32 v27, v51, v33
    s_waitcnt vmcnt(8)
    v_lshlrev_b32 v44, 16, v96
    v_and_b32 v45, 0xffff0000, v96
    v_lshlrev_b32 v46, 16, v97
    v_and_b32 v47, 0xffff0000, v97
    v_lshlrev_b32 v48, 16, v98
    v_and_b32 v49, 0xffff0000, v98
    v_lshlrev_b32 v50, 16, v99
    v_and_b32 v51, 0xffff0000, v99
    v_fmac_f32 v20, v44, v34
    v_fmac_f32 v21, v45, v34
    v_fmac_f32 v22, v46, v34
    v_fmac_f32 v23, v47, v34
    v_fmac_f32 v24, v48, v34
    v_fmac_f32 v25, v49, v34
    v_fmac_f32 v26, v50, v34
    v_fmac_f32 v27, v51, v34
    s_waitcnt vmcnt(7)
    v_lshlrev_b32 v44, 16, v100
    v_and_b32 v45, 0xffff0000, v100
    v_lshlrev_b32 v46, 16, v101
    v_and_b32 v47, 0xffff0000, v101
    v_lshlrev_b32 v48, 16, v102
    v_and_b32 v49, 0xffff0000, v102
    v_lshlrev_b32 v50, 16, v103
    v_and_b32 v51, 0xffff0000, v103
    v_fmac_f32 v20, v44, v35
    v_fmac_f32 v21, v45, v35
    v_fmac_f32 v22, v46, v35
    v_fmac_f32 v23, v47, v35
    v_fmac_f32 v24, v48, v35
    v_fmac_f32 v25, v49, v35
    v_fmac_f32 v26, v50, v35
    v_fmac_f32 v27, v51, v35
    s_waitcnt vmcnt(6)
    v_lshlrev_b32 v44, 16, v104
    v_and_b32 v45, 0xffff0000, v104
    v_lshlrev_b32 v46, 16, v105
    v_and_b32 v47, 0xffff0000, v105
    v_lshlrev_b32 v48, 16, v106
    v_and_b32 v49, 0xffff0000, v106
    v_lshlrev_b32 v50, 16, v107
    v_and_b32 v51, 0xffff0000, v107
    v_fmac_f32 v20, v44, v36
    v_fmac_f32 v21, v45, v36
    v_fmac_f32 v22, v46, v36
    v_fmac_f32 v23, v47, v36
    v_fmac_f32 v24, v48, v36
    v_fmac_f32 v25, v49, v36
    v_fmac_f32 v26, v50, v36
    v_fmac_f32 v27, v51, v36
    s_waitcnt vmcnt(5)
    v_lshlrev_b32 v44, 16, v108
    v_and_b32 v45, 0xffff0000, v108
    v_lshlrev_b32 v46, 16, v109
    v_and_b32 v47, 0xffff0000, v109
    v_lshlrev_b32 v48, 16, v110
    v_and_b32 v49, 0xffff0000, v110
    v_lshlrev_b32 v50, 16, v111
    v_and_b32 v51, 0xffff0000, v111
    v_fmac_f32 v20, v44, v37
    v_fmac_f32 v21, v45, v37
    v_fmac_f32 v22, v46, v37
    v_fmac_f32 v23, v47, v37
    v_fmac_f32 v24, v48, v37
    v_fmac_f32 v25, v49, v37
    v_fmac_f32 v26, v50, v37
    v_fmac_f32 v27, v51, v37
    s_waitcnt vmcnt(4)
    v_lshlrev_b32 v44, 16, v112
    v_and_b32 v45, 0xffff0000, v112
    v_lshlrev_b32 v46, 16, v113
    v_and_b32 v47, 0xffff0000, v113
    v_lshlrev_b32 v48, 16, v114
    v_and_b32 v49, 0xffff0000, v114
    v_lshlrev_b32 v50, 16, v115
    v_and_b32 v51, 0xffff0000, v115
    v_fmac_f32 v20, v44, v38
    v_fmac_f32 v21, v45, v38
    v_fmac_f32 v22, v46, v38
    v_fmac_f32 v23, v47, v38
    v_fmac_f32 v24, v48, v38
    v_fmac_f32 v25, v49, v38
    v_fmac_f32 v26, v50, v38
    v_fmac_f32 v27, v51, v38
    s_waitcnt vmcnt(3)
    v_lshlrev_b32 v44, 16, v116
    v_and_b32 v45, 0xffff0000, v116
    v_lshlrev_b32 v46, 16, v117
    v_and_b32 v47, 0xffff0000, v117
    v_lshlrev_b32 v48, 16, v118
    v_and_b32 v49, 0xffff0000, v118
    v_lshlrev_b32 v50, 16, v119
    v_and_b32 v51, 0xffff0000, v119
    v_fmac_f32 v20, v44, v39
    v_fmac_f32 v21, v45, v39
    v_fmac_f32 v22, v46, v39
    v_fmac_f32 v23, v47, v39
    v_fmac_f32 v24, v48, v39
    v_fmac_f32 v25, v49, v39
    v_fmac_f32 v26, v50, v39
    v_fmac_f32 v27, v51, v39
    s_waitcnt vmcnt(2)
    v_lshlrev_b32 v44, 16, v120
    v_and_b32 v45, 0xffff0000, v120
    v_lshlrev_b32 v46, 16, v121
    v_and_b32 v47, 0xffff0000, v121
    v_lshlrev_b32 v48, 16, v122
    v_and_b32 v49, 0xffff0000, v122
    v_lshlrev_b32 v50, 16, v123
    v_and_b32 v51, 0xffff0000, v123
    v_fmac_f32 v20, v44, v40
    v_fmac_f32 v21, v45, v40
    v_fmac_f32 v22, v46, v40
    v_fmac_f32 v23, v47, v40
    v_fmac_f32 v24, v48, v40
    v_fmac_f32 v25, v49, v40
    v_fmac_f32 v26, v50, v40
    v_fmac_f32 v27, v51, v40
    s_nop 1
    v_permlane32_swap_b32 v20, v24
    v_permlane32_swap_b32 v21, v25
    v_permlane32_swap_b32 v22, v26
    v_permlane32_swap_b32 v23, v27
    v_add_f32 v20, v20, v24
    v_add_f32 v21, v21, v25
    v_add_f32 v22, v22, v26
    v_add_f32 v23, v23, v27
    s_nop 1
    v_permlane16_swap_b32 v20, v22
    v_permlane16_swap_b32 v21, v23
    v_add_f32 v20, v20, v22
    v_add_f32 v21, v21, v23
    s_branch L_tail
L_s_stream:
    s_barrier
    v_lshlrev_b32 v6, 4, v8
    s_mov_b32 s68, 0
L_waitqs:
    ds_read_b32 v44, v7 offset:256
    s_waitcnt lgkmcnt(0)
    v_readfirstlane_b32 s56, v44
    s_add_u32 s68, s68, 1
    s_cmp_ge_u32 s68, 1048576
    s_cbranch_scc1 L_waitqs_done
    s_cmp_ge_u32 s56, 1
    s_cbranch_scc1 L_waitqs_done
    s_sleep 1
    s_branch L_waitqs
L_waitqs_done:
    ds_read_b128 v[28:31], v6 offset:0
    buffer_load_dwordx4 v[52:55], v2, s[20:23], 0 offen offset:0 nt
    buffer_load_dwordx4 v[56:59], v2, s[20:23], 0 offen offset:1024 nt
    buffer_load_dwordx4 v[60:63], v2, s[20:23], 0 offen offset:2048 nt
    buffer_load_dwordx4 v[64:67], v2, s[20:23], 0 offen offset:3072 nt
    buffer_load_dwordx4 v[68:71], v2, s[20:23], s58 offen offset:0 nt
    buffer_load_dwordx4 v[88:91], v2, s[24:27], 0 offen offset:0 nt
    buffer_load_dwordx4 v[92:95], v2, s[24:27], 0 offen offset:1024 nt
    buffer_load_dwordx4 v[96:99], v2, s[24:27], 0 offen offset:2048 nt
    buffer_load_dwordx4 v[100:103], v2, s[24:27], 0 offen offset:3072 nt
    buffer_load_dwordx4 v[104:107], v2, s[24:27], s58 offen offset:0 nt
    s_waitcnt lgkmcnt(0)
    s_waitcnt vmcnt(7)
    v_dot2_f32_bf16 v32, v52, v28, 0
    v_dot2_f32_bf16 v33, v56, v28, 0
    v_dot2_f32_bf16 v34, v60, v28, 0
    v_dot2_f32_bf16 v32, v53, v29, v32
    v_dot2_f32_bf16 v33, v57, v29, v33
    v_dot2_f32_bf16 v34, v61, v29, v34
    v_dot2_f32_bf16 v32, v54, v30, v32
    v_dot2_f32_bf16 v33, v58, v30, v33
    v_dot2_f32_bf16 v34, v62, v30, v34
    v_dot2_f32_bf16 v32, v55, v31, v32
    v_dot2_f32_bf16 v33, v59, v31, v33
    v_dot2_f32_bf16 v34, v63, v31, v34
    s_nop 2
    v_add_f32_dpp v32, v32, v32 row_ror:8 row_mask:0xf bank_mask:0xf
    v_add_f32_dpp v33, v33, v33 row_ror:8 row_mask:0xf bank_mask:0xf
    v_add_f32_dpp v34, v34, v34 row_ror:8 row_mask:0xf bank_mask:0xf
    v_add_f32_dpp v32, v32, v32 row_ror:4 row_mask:0xf bank_mask:0xf
    v_add_f32_dpp v33, v33, v33 row_ror:4 row_mask:0xf bank_mask:0xf
    v_add_f32_dpp v34, v34, v34 row_ror:4 row_mask:0xf bank_mask:0xf
    v_add_f32_dpp v32, v32, v32 row_ror:2 row_mask:0xf bank_mask:0xf
    v_add_f32_dpp v33, v33, v33 row_ror:2 row_mask:0xf bank_mask:0xf
    v_add_f32_dpp v34, v34, v34 row_ror:2 row_mask:0xf bank_mask:0xf
    v_add_f32_dpp v32, v32, v32 row_ror:1 row_mask:0xf bank_mask:0xf
    v_add_f32_dpp v33, v33, v33 row_ror:1 row_mask:0xf bank_mask:0xf
    v_add_f32_dpp v34, v34, v34 row_ror:1 row_mask:0xf bank_mask:0xf
    s_waitcnt vmcnt(5)
    v_dot2_f32_bf16 v35, v64, v28, 0
    v_dot2_f32_bf16 v36, v68, v28, 0
    v_dot2_f32_bf16 v35, v65, v29, v35
    v_dot2_f32_bf16 v36, v69, v29, v36
    v_dot2_f32_bf16 v35, v66, v30, v35
    v_dot2_f32_bf16 v36, v70, v30, v36
    v_dot2_f32_bf16 v35, v67, v31, v35
    v_dot2_f32_bf16 v36, v71, v31, v36
    s_nop 2
    v_add_f32_dpp v35, v35, v35 row_ror:8 row_mask:0xf bank_mask:0xf
    v_add_f32_dpp v36, v36, v36 row_ror:8 row_mask:0xf bank_mask:0xf
    s_nop 1
    v_add_f32_dpp v35, v35, v35 row_ror:4 row_mask:0xf bank_mask:0xf
    v_add_f32_dpp v36, v36, v36 row_ror:4 row_mask:0xf bank_mask:0xf
    s_nop 1
    v_add_f32_dpp v35, v35, v35 row_ror:2 row_mask:0xf bank_mask:0xf
    v_add_f32_dpp v36, v36, v36 row_ror:2 row_mask:0xf bank_mask:0xf
    s_nop 1
    v_add_f32_dpp v35, v35, v35 row_ror:1 row_mask:0xf bank_mask:0xf
    v_add_f32_dpp v36, v36, v36 row_ror:1 row_mask:0xf bank_mask:0xf
    s_nop 1
    buffer_load_dwordx4 v[52:55], v3, s[32:35], 0 offen offset:0 nt
    buffer_load_dwordx4 v[56:59], v3, s[32:35], 0 offen offset:1280 nt
    v_max3_f32 v11, v32, v33, v34
    v_max3_f32 v11, v11, v35, v36
    v_mov_b32 v44, v11
    s_nop 1
    v_permlane32_swap_b32 v11, v44
    v_max_f32 v11, v11, v44
    v_mov_b32 v44, v11
    s_nop 1
    v_permlane16_swap_b32 v11, v44
    v_max_f32 v11, v11, v44
    v_mul_f32 v11, s67, v11
    v_fma_f32 v32, v32, s67, -v11
    v_fma_f32 v33, v33, s67, -v11
    v_fma_f32 v34, v34, s67, -v11
    v_fma_f32 v35, v35, s67, -v11
    v_fma_f32 v36, v36, s67, -v11
    v_exp_f32 v32, v32
    v_exp_f32 v33, v33
    v_exp_f32 v34, v34
    v_exp_f32 v35, v35
    v_exp_f32 v36, v36
    s_nop 0
    v_add_f32 v12, v32, v33
    v_add_f32 v12, v12, v34
    v_add_f32 v12, v12, v35
    v_add_f32 v12, v12, v36
    v_mov_b32 v44, v12
    s_nop 1
    v_permlane32_swap_b32 v12, v44
    v_add_f32 v12, v12, v44
    v_mov_b32 v44, v12
    s_nop 1
    v_permlane16_swap_b32 v12, v44
    v_add_f32 v12, v12, v44
    s_waitcnt vmcnt(6)
    v_lshlrev_b32 v44, 16, v88
    v_and_b32 v45, 0xffff0000, v88
    v_lshlrev_b32 v46, 16, v89
    v_and_b32 v47, 0xffff0000, v89
    v_lshlrev_b32 v48, 16, v90
    v_and_b32 v49, 0xffff0000, v90
    v_lshlrev_b32 v50, 16, v91
    v_and_b32 v51, 0xffff0000, v91
    v_mul_f32 v20, v44, v32
    v_mul_f32 v21, v45, v32
    v_mul_f32 v22, v46, v32
    v_mul_f32 v23, v47, v32
    v_mul_f32 v24, v48, v32
    v_mul_f32 v25, v49, v32
    v_mul_f32 v26, v50, v32
    v_mul_f32 v27, v51, v32
    s_waitcnt vmcnt(5)
    v_lshlrev_b32 v44, 16, v92
    v_and_b32 v45, 0xffff0000, v92
    v_lshlrev_b32 v46, 16, v93
    v_and_b32 v47, 0xffff0000, v93
    v_lshlrev_b32 v48, 16, v94
    v_and_b32 v49, 0xffff0000, v94
    v_lshlrev_b32 v50, 16, v95
    v_and_b32 v51, 0xffff0000, v95
    v_fmac_f32 v20, v44, v33
    v_fmac_f32 v21, v45, v33
    v_fmac_f32 v22, v46, v33
    v_fmac_f32 v23, v47, v33
    v_fmac_f32 v24, v48, v33
    v_fmac_f32 v25, v49, v33
    v_fmac_f32 v26, v50, v33
    v_fmac_f32 v27, v51, v33
    s_waitcnt vmcnt(4)
    v_lshlrev_b32 v44, 16, v96
    v_and_b32 v45, 0xffff0000, v96
    v_lshlrev_b32 v46, 16, v97
    v_and_b32 v47, 0xffff0000, v97
    v_lshlrev_b32 v48, 16, v98
    v_and_b32 v49, 0xffff0000, v98
    v_lshlrev_b32 v50, 16, v99
    v_and_b32 v51, 0xffff0000, v99
    v_fmac_f32 v20, v44, v34
    v_fmac_f32 v21, v45, v34
    v_fmac_f32 v22, v46, v34
    v_fmac_f32 v23, v47, v34
    v_fmac_f32 v24, v48, v34
    v_fmac_f32 v25, v49, v34
    v_fmac_f32 v26, v50, v34
    v_fmac_f32 v27, v51, v34
    s_waitcnt vmcnt(3)
    v_lshlrev_b32 v44, 16, v100
    v_and_b32 v45, 0xffff0000, v100
    v_lshlrev_b32 v46, 16, v101
    v_and_b32 v47, 0xffff0000, v101
    v_lshlrev_b32 v48, 16, v102
    v_and_b32 v49, 0xffff0000, v102
    v_lshlrev_b32 v50, 16, v103
    v_and_b32 v51, 0xffff0000, v103
    v_fmac_f32 v20, v44, v35
    v_fmac_f32 v21, v45, v35
    v_fmac_f32 v22, v46, v35
    v_fmac_f32 v23, v47, v35
    v_fmac_f32 v24, v48, v35
    v_fmac_f32 v25, v49, v35
    v_fmac_f32 v26, v50, v35
    v_fmac_f32 v27, v51, v35
    s_waitcnt vmcnt(2)
    v_lshlrev_b32 v44, 16, v104
    v_and_b32 v45, 0xffff0000, v104
    v_lshlrev_b32 v46, 16, v105
    v_and_b32 v47, 0xffff0000, v105
    v_lshlrev_b32 v48, 16, v106
    v_and_b32 v49, 0xffff0000, v106
    v_lshlrev_b32 v50, 16, v107
    v_and_b32 v51, 0xffff0000, v107
    v_fmac_f32 v20, v44, v36
    v_fmac_f32 v21, v45, v36
    v_fmac_f32 v22, v46, v36
    v_fmac_f32 v23, v47, v36
    v_fmac_f32 v24, v48, v36
    v_fmac_f32 v25, v49, v36
    v_fmac_f32 v26, v50, v36
    v_fmac_f32 v27, v51, v36
    s_nop 1
    v_permlane32_swap_b32 v20, v24
    v_permlane32_swap_b32 v21, v25
    v_permlane32_swap_b32 v22, v26
    v_permlane32_swap_b32 v23, v27
    v_add_f32 v20, v20, v24
    v_add_f32 v21, v21, v25
    v_add_f32 v22, v22, v26
    v_add_f32 v23, v23, v27
    s_nop 1
    v_permlane16_swap_b32 v20, v22
    v_permlane16_swap_b32 v21, v23
    v_add_f32 v20, v20, v22
    v_add_f32 v21, v21, v23
L_tail:
    ds_write_b64 v4, v[20:21] offset:8192
    s_lshl_b32 s55, s54, 2
    v_mov_b32 v45, s55
    ds_write_b32 v45, v11 offset:512
    ds_write_b32 v45, v12 offset:576
    v_mov_b32 v13, 0x01010101
    s_lshl_b32 s55, s53, 2
    s_cmp_lg_u32 s55, s52
    s_cbranch_scc1 L_nocnt
    s_sub_u32 s57, s54, 1
    s_cmp_ge_u32 s57, 8
    s_cbranch_scc1 L_nocnt
    buffer_load_dword v13, v14, s[48:51], 0 offen sc1
L_nocnt:
    s_waitcnt vmcnt(0)
    v_lshlrev_b32 v60, 16, v52
    v_and_b32 v61, 0xffff0000, v52
    v_lshlrev_b32 v62, 16, v53
    v_and_b32 v63, 0xffff0000, v53
    v_lshlrev_b32 v64, 16, v54
    v_and_b32 v65, 0xffff0000, v54
    v_lshlrev_b32 v66, 16, v55
    v_and_b32 v67, 0xffff0000, v55
    v_lshlrev_b32 v68, 16, v56
    v_and_b32 v69, 0xffff0000, v56
    v_lshlrev_b32 v70, 16, v57
    v_and_b32 v71, 0xffff0000, v57
    v_lshlrev_b32 v72, 16, v58
    v_and_b32 v73, 0xffff0000, v58
    v_lshlrev_b32 v74, 16, v59
    v_and_b32 v75, 0xffff0000, v59
    s_waitcnt lgkmcnt(0)
    s_barrier
    s_cmp_lg_u32 s54, 0
    s_cbranch_scc1 L_nopub1
    ds_read_b128 v[28:31], v7 offset:512
    ds_read_b128 v[32:35], v7 offset:528
    ds_read_b128 v[36:39], v7 offset:544
    ds_read_b128 v[40:43], v7 offset:560
    ds_read_b128 v[76:79], v7 offset:576
    ds_read_b128 v[80:83], v7 offset:592
    ds_read_b128 v[84:87], v7 offset:608
    ds_read_b128 v[120:123], v7 offset:624
    ds_read_b64 v[88:89], v5 offset:8192
    ds_read_b64 v[90:91], v5 offset:8704
    ds_read_b64 v[92:93], v5 offset:9216
    ds_read_b64 v[94:95], v5 offset:9728
    ds_read_b64 v[96:97], v5 offset:10240
    ds_read_b64 v[98:99], v5 offset:10752
    ds_read_b64 v[100:101], v5 offset:11264
    ds_read_b64 v[102:103], v5 offset:11776
    ds_read_b64 v[104:105], v5 offset:12288
    ds_read_b64 v[106:107], v5 offset:12800
    ds_read_b64 v[108:109], v5 offset:13312
    ds_read_b64 v[110:111], v5 offset:13824
    ds_read_b64 v[112:113], v5 offset:14336
    ds_read_b64 v[114:115], v5 offset:14848
    ds_read_b64 v[116:117], v5 offset:15360
    ds_read_b64 v[118:119], v5 offset:15872
    s_waitcnt lgkmcnt(15)
    v_max3_f32 v11, v28, v29, v30
    v_max3_f32 v11, v11, v31, v32
    v_max3_f32 v11, v11, v33, v34
    v_max3_f32 v11, v11, v35, v36
    v_max3_f32 v11, v11, v37, v38
    v_max3_f32 v11, v11, v39, v40
    v_max3_f32 v11, v11, v41, v42
    v_max_f32 v11, v11, v43
    v_sub_f32 v28, v28, v11
    v_sub_f32 v29, v29, v11
    v_sub_f32 v30, v30, v11
    v_sub_f32 v31, v31, v11
    v_sub_f32 v32, v32, v11
    v_sub_f32 v33, v33, v11
    v_sub_f32 v34, v34, v11
    v_sub_f32 v35, v35, v11
    v_sub_f32 v36, v36, v11
    v_sub_f32 v37, v37, v11
    v_sub_f32 v38, v38, v11
    v_sub_f32 v39, v39, v11
    v_sub_f32 v40, v40, v11
    v_sub_f32 v41, v41, v11
    v_sub_f32 v42, v42, v11
    v_sub_f32 v43, v43, v11
    v_exp_f32 v28, v28
    v_exp_f32 v29, v29
    v_exp_f32 v30, v30
    v_exp_f32 v31, v31
    v_exp_f32 v32, v32
    v_exp_f32 v33, v33
    v_exp_f32 v34, v34
    v_exp_f32 v35, v35
    v_exp_f32 v36, v36
    v_exp_f32 v37, v37
    v_exp_f32 v38, v38
    v_exp_f32 v39, v39
    v_exp_f32 v40, v40
    v_exp_f32 v41, v41
    v_exp_f32 v42, v42
    v_exp_f32 v43, v43
    s_waitcnt lgkmcnt(0)
    v_mul_f32 v20, v28, v88
    v_mul_f32 v21, v28, v89
    v_mul_f32 v23, v28, v76
    v_mul_f32 v24, v29, v90
    v_mul_f32 v25, v29, v91
    v_mul_f32 v27, v29, v77
    v_fmac_f32 v20, v30, v92
    v_fmac_f32 v21, v30, v93
    v_fmac_f32 v23, v30, v78
    v_fmac_f32 v24, v31, v94
    v_fmac_f32 v25, v31, v95
    v_fmac_f32 v27, v31, v79
    v_fmac_f32 v20, v32, v96
    v_fmac_f32 v21, v32, v97
    v_fmac_f32 v23, v32, v80
    v_fmac_f32 v24, v33, v98
    v_fmac_f32 v25, v33, v99
    v_fmac_f32 v27, v33, v81
    v_fmac_f32 v20, v34, v100
    v_fmac_f32 v21, v34, v101
    v_fmac_f32 v23, v34, v82
    v_fmac_f32 v24, v35, v102
    v_fmac_f32 v25, v35, v103
    v_fmac_f32 v27, v35, v83
    v_fmac_f32 v20, v36, v104
    v_fmac_f32 v21, v36, v105
    v_fmac_f32 v23, v36, v84
    v_fmac_f32 v24, v37, v106
    v_fmac_f32 v25, v37, v107
    v_fmac_f32 v27, v37, v85
    v_fmac_f32 v20, v38, v108
    v_fmac_f32 v21, v38, v109
    v_fmac_f32 v23, v38, v86
    v_fmac_f32 v24, v39, v110
    v_fmac_f32 v25, v39, v111
    v_fmac_f32 v27, v39, v87
    v_fmac_f32 v20, v40, v112
    v_fmac_f32 v21, v40, v113
    v_fmac_f32 v23, v40, v120
    v_fmac_f32 v24, v41, v114
    v_fmac_f32 v25, v41, v115
    v_fmac_f32 v27, v41, v121
    v_fmac_f32 v20, v42, v116
    v_fmac_f32 v21, v42, v117
    v_fmac_f32 v23, v42, v122
    v_fmac_f32 v24, v43, v118
    v_fmac_f32 v25, v43, v119
    v_fmac_f32 v27, v43, v123
    v_add_f32 v20, v20, v24
    v_add_f32 v21, v21, v25
    v_add_f32 v23, v23, v27
    v_min_u32 v20, -2, v20
    v_min_u32 v21, -2, v21
    v_min_u32 v22, -2, v11
    v_min_u32 v23, -2, v23
    buffer_store_dwordx4 v[20:23], v16, s[40:43], s65 offen sc1
    s_cmp_ge_u32 s53, 5
    s_cbranch_scc1 L_end
    s_mov_b32 s71, 0xff
    s_mov_b32 s68, 0
L_poll1:
    s_bitcmp1_b32 s71, 0
    s_cbranch_scc0 L_p1s0
    s_add_u32 s55, s63, 0
    buffer_load_dwordx4 v[88:91], v16, s[40:43], s55 offen sc1
L_p1s0:
    s_bitcmp1_b32 s71, 1
    s_cbranch_scc0 L_p1s1
    s_add_u32 s55, s63, 2048
    buffer_load_dwordx4 v[92:95], v16, s[40:43], s55 offen sc1
L_p1s1:
    s_bitcmp1_b32 s71, 2
    s_cbranch_scc0 L_p1s2
    s_add_u32 s55, s63, 4096
    buffer_load_dwordx4 v[96:99], v16, s[40:43], s55 offen sc1
L_p1s2:
    s_bitcmp1_b32 s71, 3
    s_cbranch_scc0 L_p1s3
    s_add_u32 s55, s63, 6144
    buffer_load_dwordx4 v[100:103], v16, s[40:43], s55 offen sc1
L_p1s3:
    s_bitcmp1_b32 s71, 4
    s_cbranch_scc0 L_p1s4
    s_add_u32 s55, s63, 8192
    buffer_load_dwordx4 v[104:107], v16, s[40:43], s55 offen sc1
L_p1s4:
    s_bitcmp1_b32 s71, 5
    s_cbranch_scc0 L_p1s5
    s_add_u32 s55, s63, 10240
    buffer_load_dwordx4 v[108:111], v16, s[40:43], s55 offen sc1
L_p1s5:
    s_bitcmp1_b32 s71, 6
    s_cbranch_scc0 L_p1s6
    s_add_u32 s55, s63, 12288
    buffer_load_dwordx4 v[112:115], v16, s[40:43], s55 offen sc1
L_p1s6:
    s_bitcmp1_b32 s71, 7
    s_cbranch_scc0 L_p1s7
    s_add_u32 s55, s63, 14336
    buffer_load_dwordx4 v[116:119], v16, s[40:43], s55 offen sc1
L_p1s7:
    s_waitcnt vmcnt(0)
    v_max3_u32 v44, v88, v89, v90
    v_max_u32 v44, v44, v91
    v_cmp_eq_u32 s[4:5], -1, v44
    v_max3_u32 v45, v92, v93, v94
    v_max_u32 v45, v45, v95
    v_cmp_eq_u32 s[6:7], -1, v45
    v_max3_u32 v46, v96, v97, v98
    v_max_u32 v46, v46, v99
    v_cmp_eq_u32 s[8:9], -1, v46
    v_max3_u32 v47, v100, v101, v102
    v_max_u32 v47, v47, v103
    v_cmp_eq_u32 s[10:11], -1, v47
    v_max3_u32 v44, v104, v105, v106
    v_max_u32 v44, v44, v107
    v_cmp_eq_u32 s[12:13], -1, v44
    v_max3_u32 v45, v108, v109, v110
    v_max_u32 v45, v45, v111
    v_cmp_eq_u32 s[14:15], -1, v45
    v_max3_u32 v46, v112, v113, v114
    v_max_u32 v46, v46, v115
    v_cmp_eq_u32 s[16:17], -1, v46
    v_max3_u32 v47, v116, v117, v118
    v_max_u32 v47, v47, v119
    v_cmp_eq_u32 s[18:19], -1, v47
    s_nop 3
    s_cmp_eq_u64 s[4:5], 0
    s_cbranch_scc0 L_p1k0
    s_bitset0_b32 s71, 0
L_p1k0:
    s_cmp_eq_u64 s[6:7], 0
    s_cbranch_scc0 L_p1k1
    s_bitset0_b32 s71, 1
L_p1k1:
    s_cmp_eq_u64 s[8:9], 0
    s_cbranch_scc0 L_p1k2
    s_bitset0_b32 s71, 2
L_p1k2:
    s_cmp_eq_u64 s[10:11], 0
    s_cbranch_scc0 L_p1k3
    s_bitset0_b32 s71, 3
L_p1k3:
    s_cmp_eq_u64 s[12:13], 0
    s_cbranch_scc0 L_p1k4
    s_bitset0_b32 s71, 4
L_p1k4:
    s_cmp_eq_u64 s[14:15], 0
    s_cbranch_scc0 L_p1k5
    s_bitset0_b32 s71, 5
L_p1k5:
    s_cmp_eq_u64 s[16:17], 0
    s_cbranch_scc0 L_p1k6
    s_bitset0_b32 s71, 6
L_p1k6:
    s_cmp_eq_u64 s[18:19], 0
    s_cbranch_scc0 L_p1k7
    s_bitset0_b32 s71, 7
L_p1k7:
    s_add_u32 s68, s68, 1
    s_cmp_ge_u32 s68, 1048576
    s_cbranch_scc1 L_poll1_done
    s_cmp_eq_u32 s71, 0
    s_cbranch_scc1 L_poll1_done
    s_bcnt1_i32_b32 s55, s71
    s_cmp_lt_u32 s55, 3
    s_cbranch_scc1 L_poll1
    s_sleep 8
    s_branch L_poll1
L_poll1_done:
    v_max3_f32 v11, v90, v94, v98
    v_max3_f32 v11, v11, v102, v106
    v_max3_f32 v11, v11, v110, v114
    v_max_f32 v11, v11, v118
    v_sub_f32 v90, v90, v11
    v_sub_f32 v94, v94, v11
    v_sub_f32 v98, v98, v11
    v_sub_f32 v102, v102, v11
    v_sub_f32 v106, v106, v11
    v_sub_f32 v110, v110, v11
    v_sub_f32 v114, v114, v11
    v_sub_f32 v118, v118, v11
    v_exp_f32 v90, v90
    v_exp_f32 v94, v94
    v_exp_f32 v98, v98
    v_exp_f32 v102, v102
    v_exp_f32 v106, v106
    v_exp_f32 v110, v110
    v_exp_f32 v114, v114
    v_exp_f32 v118, v118
    s_nop 0
    v_mul_f32 v12, v90, v91
    v_mul_f32 v44, v90, v88
    v_mul_f32 v45, v90, v89
    v_fmac_f32 v12, v94, v95
    v_fmac_f32 v44, v94, v92
    v_fmac_f32 v45, v94, v93
    v_fmac_f32 v12, v98, v99
    v_fmac_f32 v44, v98, v96
    v_fmac_f32 v45, v98, v97
    v_fmac_f32 v12, v102, v103
    v_fmac_f32 v44, v102, v100
    v_fmac_f32 v45, v102, v101
    v_fmac_f32 v12, v106, v107
    v_fmac_f32 v44, v106, v104
    v_fmac_f32 v45, v106, v105
    v_fmac_f32 v12, v110, v111
    v_fmac_f32 v44, v110, v108
    v_fmac_f32 v45, v110, v109
    v_fmac_f32 v12, v114, v115
    v_fmac_f32 v44, v114, v112
    v_fmac_f32 v45, v114, v113
    v_fmac_f32 v12, v118, v119
    v_fmac_f32 v44, v118, v116
    v_fmac_f32 v45, v118, v117
    v_rcp_f32 v12, v12
    s_nop 0
    v_mul_f32 v44, v12, v44
    v_mul_f32 v45, v12, v45
    ds_write_b64 v5, v[44:45] offset:1024
    s_waitcnt lgkmcnt(0)
    s_branch L_b3b
L_nopub1:
    s_cmp_ge_u32 s53, 5
    s_cbranch_scc1 L_end
L_b3b:
    s_barrier
    ds_read_b64 v[44:45], v10 offset:1024
    s_waitcnt lgkmcnt(0)
    v_mul_f32 v20, v44, v60
    v_mul_f32 v21, v44, v61
    v_mul_f32 v22, v44, v62
    v_mul_f32 v23, v44, v63
    v_mul_f32 v24, v44, v64
    v_mul_f32 v25, v44, v65
    v_mul_f32 v26, v44, v66
    v_mul_f32 v27, v44, v67
    v_fmac_f32 v20, v45, v68
    v_fmac_f32 v21, v45, v69
    v_fmac_f32 v22, v45, v70
    v_fmac_f32 v23, v45, v71
    v_fmac_f32 v24, v45, v72
    v_fmac_f32 v25, v45, v73
    v_fmac_f32 v26, v45, v74
    v_fmac_f32 v27, v45, v75
    s_nop 1
    v_permlane32_swap_b32 v20, v24
    v_permlane32_swap_b32 v21, v25
    v_permlane32_swap_b32 v22, v26
    v_permlane32_swap_b32 v23, v27
    v_add_f32 v20, v20, v24
    v_add_f32 v21, v21, v25
    v_add_f32 v22, v22, v26
    v_add_f32 v23, v23, v27
    s_nop 1
    v_permlane16_swap_b32 v20, v22
    v_permlane16_swap_b32 v21, v23
    v_add_f32 v20, v20, v22
    v_add_f32 v21, v21, v23
    ds_write_b64 v4, v[20:21] offset:16384
    s_waitcnt lgkmcnt(0)
    s_barrier
    s_cmp_lg_u32 s54, 0
    s_cbranch_scc1 L_nopub2
    ds_read_b64 v[88:89], v5 offset:16384
    ds_read_b64 v[90:91], v5 offset:16896
    ds_read_b64 v[92:93], v5 offset:17408
    ds_read_b64 v[94:95], v5 offset:17920
    ds_read_b64 v[96:97], v5 offset:18432
    ds_read_b64 v[98:99], v5 offset:18944
    ds_read_b64 v[100:101], v5 offset:19456
    ds_read_b64 v[102:103], v5 offset:19968
    ds_read_b64 v[104:105], v5 offset:20480
    ds_read_b64 v[106:107], v5 offset:20992
    ds_read_b64 v[108:109], v5 offset:21504
    ds_read_b64 v[110:111], v5 offset:22016
    ds_read_b64 v[112:113], v5 offset:22528
    ds_read_b64 v[114:115], v5 offset:23040
    ds_read_b64 v[116:117], v5 offset:23552
    ds_read_b64 v[118:119], v5 offset:24064
    s_waitcnt lgkmcnt(0)
    v_add_f32 v88, v88, v90
    v_add_f32 v89, v89, v91
    v_add_f32 v92, v92, v94
    v_add_f32 v93, v93, v95
    v_add_f32 v96, v96, v98
    v_add_f32 v97, v97, v99
    v_add_f32 v100, v100, v102
    v_add_f32 v101, v101, v103
    v_add_f32 v104, v104, v106
    v_add_f32 v105, v105, v107
    v_add_f32 v108, v108, v110
    v_add_f32 v109, v109, v111
    v_add_f32 v112, v112, v114
    v_add_f32 v113, v113, v115
    v_add_f32 v116, v116, v118
    v_add_f32 v117, v117, v119
    v_add_f32 v88, v88, v92
    v_add_f32 v89, v89, v93
    v_add_f32 v96, v96, v100
    v_add_f32 v97, v97, v101
    v_add_f32 v104, v104, v108
    v_add_f32 v105, v105, v109
    v_add_f32 v112, v112, v116
    v_add_f32 v113, v113, v117
    v_add_f32 v88, v88, v96
    v_add_f32 v89, v89, v97
    v_add_f32 v104, v104, v112
    v_add_f32 v105, v105, v113
    v_add_f32 v20, v88, v104
    v_add_f32 v21, v89, v105
    v_min_u32 v20, -2, v20
    v_min_u32 v21, -2, v21
    buffer_store_dwordx2 v[20:21], v5, s[40:43], s66 offen sc1
L_nopub2:
    s_lshl_b32 s55, s53, 2
    s_cmp_lg_u32 s55, s52
    s_cbranch_scc1 L_end
    s_sub_u32 s57, s54, 1
    s_cmp_ge_u32 s57, 8
    s_cbranch_scc1 L_end
    s_mov_b32 s68, 0
    v_mov_b32 v44, 0x01010101
L_ready:
    v_cmp_ne_u32 vcc, v44, v13
    s_add_u32 s68, s68, 1
    s_cmp_ge_u32 s68, 1048576
    s_cbranch_scc1 L_ready_ok
    s_nop 1
    s_cbranch_vccz L_ready_ok
    buffer_load_dword v13, v14, s[48:51], 0 offen sc1
    s_waitcnt vmcnt(0)
    s_branch L_ready
L_ready_ok:
    v_lshrrev_b32 v44, 2, v1
    v_and_b32 v45, 3, v1
    v_lshlrev_b32 v17, 10, v44
    v_lshl_add_u32 v17, v45, 4, v17
    s_lshl_b32 s55, s57, 6
    s_add_u32 s55, s55, s69
    s_add_u32 s56, s55, 16384
    s_mov_b32 s68, 0
L_poll2:
    buffer_load_dwordx4 v[88:91], v17, s[40:43], s55 offen sc1
    buffer_load_dwordx4 v[92:95], v17, s[40:43], s56 offen sc1
    s_waitcnt vmcnt(0)
    v_max3_u32 v44, v88, v89, v90
    v_max3_u32 v44, v44, v91, v92
    v_max3_u32 v44, v44, v93, v94
    v_max_u32 v44, v44, v95
    v_cmp_eq_u32 vcc, -1, v44
    s_add_u32 s68, s68, 1
    s_cmp_ge_u32 s68, 1048576
    s_cbranch_scc1 L_poll2_done
    s_cbranch_vccz L_poll2_done
    s_branch L_poll2
L_poll2_done:
    v_add_f32 v20, v88, v92
    v_add_f32 v21, v89, v93
    v_add_f32 v22, v90, v94
    v_add_f32 v23, v91, v95
    s_nop 1
    v_add_f32_dpp v20, v20, v20 row_ror:4 row_mask:0xf bank_mask:0xf
    v_add_f32_dpp v21, v21, v21 row_ror:4 row_mask:0xf bank_mask:0xf
    v_add_f32_dpp v22, v22, v22 row_ror:4 row_mask:0xf bank_mask:0xf
    v_add_f32_dpp v23, v23, v23 row_ror:4 row_mask:0xf bank_mask:0xf
    s_nop 1
    v_add_f32_dpp v20, v20, v20 row_ror:8 row_mask:0xf bank_mask:0xf
    v_add_f32_dpp v21, v21, v21 row_ror:8 row_mask:0xf bank_mask:0xf
    v_add_f32_dpp v22, v22, v22 row_ror:8 row_mask:0xf bank_mask:0xf
    v_add_f32_dpp v23, v23, v23 row_ror:8 row_mask:0xf bank_mask:0xf
    s_nop 1
    v_mov_b32 v24, v20
    v_mov_b32 v25, v21
    v_mov_b32 v26, v22
    v_mov_b32 v27, v23
    s_nop 1
    v_permlane32_swap_b32 v20, v24
    v_permlane32_swap_b32 v21, v25
    v_permlane32_swap_b32 v22, v26
    v_permlane32_swap_b32 v23, v27
    v_add_f32 v20, v20, v24
    v_add_f32 v21, v21, v25
    v_add_f32 v22, v22, v26
    v_add_f32 v23, v23, v27
    v_mov_b32 v24, v20
    v_mov_b32 v25, v21
    v_mov_b32 v26, v22
    v_mov_b32 v27, v23
    s_nop 1
    v_permlane16_swap_b32 v20, v24
    v_permlane16_swap_b32 v21, v25
    v_permlane16_swap_b32 v22, v26
    v_permlane16_swap_b32 v23, v27
    v_add_f32 v20, v20, v24
    v_add_f32 v21, v21, v25
    v_add_f32 v22, v22, v26
    v_add_f32 v23, v23, v27
    v_cvt_pk_bf16_f32 v20, v20, v21
    v_cvt_pk_bf16_f32 v21, v22, v23
    s_lshl_b32 s55, s53, 8
    s_lshl_b32 s56, s57, 5
    s_add_u32 s55, s55, s56
    v_lshlrev_b32 v45, 3, v45
    s_mov_b64 exec, 15
    buffer_store_dwordx2 v[20:21], v45, s[44:47], s55 offen
L_end:
    s_endpgm
.section .rodata,"a"
.p2align 6
.amdhsa_kernel standalone__sliding_block_cached__decode_kernel
  .amdhsa_next_free_vgpr 128
  .amdhsa_next_free_sgpr 96
  .amdhsa_accum_offset 128
  .amdhsa_group_segment_fixed_size 0
  .amdhsa_kernarg_size 64
  .amdhsa_user_sgpr_count 2
  .amdhsa_user_sgpr_kernarg_segment_ptr 1
  .amdhsa_system_sgpr_workgroup_id_x 1
.end_amdhsa_kernel
```
